```python
import torch

def _softmax(x, axis=-1):
    return torch.softmax(x, dim=axis)
def _gelu(x):
    return torch.nn.functional.gelu(x, approximate="tanh")
def _silu(x):
    return torch.nn.functional.silu(x)
def _sigmoid(x):
    return torch.sigmoid(x)
def _layernorm(x, axis=-1, eps=1e-5):
    m = x.mean(dim=axis, keepdim=True)
    v = x.var(dim=axis, keepdim=True, unbiased=False)
    return (x - m) / torch.sqrt(v + eps)
def _scatter_add(tgt, idx, src, axis=0):
    return tgt.clone().index_add_(axis, idx, src)
def _segment_sum(src, seg, n):
    out = torch.zeros((n,) + src.shape[1:], dtype=src.dtype)
    return out.index_add_(0, seg, src)
def _pad(x, pw):
    flat = tuple(v for pair in reversed(pw) for v in pair)
    return torch.nn.functional.pad(x, flat)

kernel_name = 'standalone__qk_norm__prompt'

def setup_inputs():

    _w = (lambda a: (lambda t: t.to(torch.bfloat16) if t.is_floating_point() else t)(torch.as_tensor(a)))
    B, H, S, D = 2, 32, 2048, 640
    Dh = D // H
    return {
        "q": _w((lambda *s: torch.randn(*s, dtype=torch.bfloat16) * 0.05)(B, H, S, Dh)),
        "k": _w((lambda *s: torch.randn(*s, dtype=torch.bfloat16) * 0.05)(B, H, S, Dh)),
        "v": _w((lambda *s: torch.randn(*s, dtype=torch.bfloat16) * 0.8)(B, H, S, Dh)),
        "t": _w(torch.abs((lambda *s: torch.randn(*s, dtype=torch.bfloat16) * 0.8)(H)) + 1.0),
    }

def reference(q, k, v, t):
    eps = 1e-6
    qn = q / (torch.sqrt((q * q).sum(axis=-1, keepdims=True)) + eps)
    kn = k / (torch.sqrt((k * k).sum(axis=-1, keepdims=True)) + eps)
    logits = torch.einsum('bhqd,bhkd->bhqk', qn, kn) * t[None, :, None, None]
    attn = _softmax(logits, axis=-1)
    return torch.einsum('bhqk,bhkd->bhqd', attn, v)
```

```asm
; @launch grid=(256,1,1) block=(1024,1,1) lds=147520
.amdgcn_target "amdgcn-amd-amdhsa--gfx950"
.text
.globl standalone__qk_norm__prompt_kernel
.p2align 8
.type standalone__qk_norm__prompt_kernel,@function
standalone__qk_norm__prompt_kernel:
    s_cmp_ge_u32 s2, 256
    s_cbranch_scc1 L_end
    s_setprio 3
    s_load_dwordx8 s[4:11], s[0:1], 0
    s_load_dwordx2 s[12:13], s[0:1], 32
    v_lshrrev_b32 v1, 6, v0
    v_and_b32 v0, 63, v0
    v_readfirstlane_b32 s42, v1
    v_mul_u32_u24 v108, 40, v0
    v_lshlrev_b32 v96, 2, v1
    v_add_u32 v96, 147456, v96
    v_mov_b32 v2, 0
    ds_write_b32 v96, v2
    s_and_b32 s28, s2, 7
    s_lshr_b32 s29, s2, 5
    s_lshl_b32 s29, s29, 3
    s_add_u32 s28, s28, s29
    s_bfe_u32 s29, s2, 0x20003
    s_mul_i32 s16, s28, 81920
    s_mul_i32 s29, s29, 20480
    s_add_u32 s17, s16, s29
    s_and_b32 s28, s28, 31
    s_lshr_b32 s30, s28, 1
    s_lshl_b32 s30, s30, 2
    s_and_b32 s28, s28, 1
    s_lshl_b32 s32, s28, 4
    s_mov_b32 s22, 5242880
    s_mov_b32 s23, 0x00020000
    s_mov_b32 s26, 5242880
    s_mov_b32 s27, 0x00020000
    s_lshr_b32 s40, s42, 3
    s_bfe_u32 s80, s42, 0x10002
    s_and_b32 s28, s42, 3
    s_lshl_b32 s29, s40, 2
    s_or_b32 s49, s28, s29
    s_mul_i32 s34, s49, 10240
    s_add_u32 s34, s34, s16
    s_and_b32 s29, s42, 7
    s_mul_i32 s14, s29, 2560
    s_add_u32 s14, s14, s17
    s_cmp_eq_u32 s40, 1
    s_cselect_b32 s14, s14, s34
    s_cselect_b32 s48, 1, 0
    s_cselect_b32 s47, 4, 3
    s_cselect_b32 s18, 0, 2560
    s_add_u32 s18, s18, s34
    s_cmp_eq_u32 s80, 0
    s_waitcnt lgkmcnt(0)
    s_load_dword s33, s[10:11], s30
    s_cselect_b32 s20, s6, s8
    s_cselect_b32 s21, s7, s9
    s_cmp_eq_u32 s48, 1
    s_cselect_b32 s24, s4, s20
    s_cselect_b32 s25, s5, s21
    s_cmp_eq_u32 s48, 1
    s_cbranch_scc1 L_qld
    buffer_load_dwordx4 v[16:19], v108, s[24:27], s14 offen
    buffer_load_dwordx4 v[20:23], v108, s[24:27], s14 offen offset:16
    buffer_load_dwordx2 v[24:25], v108, s[24:27], s14 offen offset:32
    s_branch L_nofirst
L_qld:
    v_lshlrev_b32 v3, 4, v0
    v_lshlrev_b32 v4, 3, v0
    buffer_load_dwordx4 v[16:19], v3, s[24:27], s14 offen nt
    buffer_load_dwordx4 v[20:23], v3, s[24:27], s14 offen offset:1024 nt
    buffer_load_dwordx2 v[24:25], v4, s[24:27], s14 offen offset:2048 nt
L_nofirst:
    s_mov_b32 s84, s12
    s_mov_b32 s85, s13
    s_mov_b32 s86, 5242880
    s_mov_b32 s87, 0x00020000
    s_setprio 0
    s_mov_b32 s36, 0xffff0000
    s_mov_b32 s45, 49152
    s_mov_b32 s46, 4294868992
    s_and_b32 s28, s49, 1
    s_lshl_b32 s28, s28, 1
    s_and_b32 s29, s49, 2
    s_lshl_b32 s29, s29, 2
    s_or_b32 s28, s28, s29
    s_andn2_b32 s29, 4, s49
    s_or_b32 s28, s28, s29
    s_mul_i32 s3, s28, 3072
    s_mul_i32 s28, s48, 49152
    s_add_u32 s3, s3, s28
    s_cmp_eq_u32 s80, 0
    s_cselect_b32 s28, 16, 48
    s_movk_i32 s30, 1536
    s_cselect_b32 s29, 2560, s30
    s_cselect_b32 s30, 0, s30
    s_add_u32 s3, s3, s30
    v_lshrrev_b32 v1, 5, v0
    v_mul_u32_u24 v2, s28, v0
    v_mad_u32_u24 v2, v1, s29, v2
    v_add_u32 v107, s3, v2
    s_mul_i32 s28, s40, 24576
    v_lshl_add_u32 v104, v0, 4, s28
    v_and_b32 v2, 31, v0
    v_lshl_add_u32 v105, v2, 3, s28
    v_lshlrev_b32 v2, 3, v2
    v_sub_u32 v124, v107, v2
    v_add_u32 v124, 1024, v124
    s_add_u32 s28, s28, 1536
    v_bfe_u32 v2, v0, 2, 2
    v_mad_u32_u24 v2, v2, 48, s28
    v_and_b32 v3, 3, v0
    v_and_b32 v4, 18, v0
    v_cmp_eq_u32 vcc, 18, v4
    s_nop 1
    v_cndmask_b32 v3, v3, 1, vcc
    v_lshl_add_u32 v2, v3, 3, v2
    v_and_b32 v3, 16, v0
    v_lshl_add_u32 v2, v3, 1, v2
    s_movk_i32 s29, 192
    v_mad_u32_u24 v106, v1, s29, v2
    v_mov_b32 v120, 0x3f80
    v_mov_b32 v121, 0
    v_mov_b32 v100, 0
    v_mov_b32 v101, 0
    v_mov_b32 v102, 0
    v_mov_b32 v103, 0
    v_mfma_f32_32x32x8_bf16 v[48:63], v[100:101], v[100:101], 0
    v_mfma_f32_32x32x8_bf16 v[64:79], v[100:101], v[100:101], 0
    s_mul_i32 s28, s42, 3072
    s_add_u32 s28, s28, 98304
    v_lshl_add_u32 v109, v0, 4, s28
    s_xor_b32 s29, s42, 8
    s_mul_i32 s29, s29, 3072
    s_add_u32 s29, s29, 98304
    v_lshl_add_u32 v122, v0, 4, s29
    s_movk_i32 s29, -1264
    v_mad_i32_i24 v123, v1, s29, v108
    s_and_b32 s28, s42, 7
    s_lshl_b32 s28, s28, 1
    s_add_u32 s28, s28, s40
    s_mul_i32 s15, s28, 1280
    s_add_u32 s15, s15, s17
    s_and_b32 s28, s42, 7
    s_mul_i32 s28, s28, 3072
    s_add_u32 s28, s28, 98304
    s_lshl_b32 s29, s40, 10
    s_add_u32 s30, s28, s29
    v_lshl_add_u32 v11, v0, 4, s30
    s_xor_b32 s29, s29, 1024
    s_add_u32 s30, s28, s29
    v_lshl_add_u32 v12, v0, 4, s30
    s_lshl_b32 s29, s40, 5
    v_xor_b32 v13, s29, v0
    v_lshl_add_u32 v13, v13, 3, s28
    v_and_b32 v2, 15, v0
    v_lshlrev_b32 v2, 2, v2
    v_add_u32 v97, 147456, v2
    s_or_b32 s28, s42, 8
    s_lshl_b32 s35, 1, s28
    s_lshl_b32 s28, s40, 1
    s_lshl_b32 s29, 0x33, s28
    s_or_b32 s35, s35, s29
    s_barrier
    s_setprio 3
    s_waitcnt lgkmcnt(0)
    s_lshr_b32 s33, s33, s32
    s_lshl_b32 s37, s33, 16
    s_and_b32 s38, s37, 0x7fffffff
    s_cmp_le_u32 s38, 0x41300000
    s_cselect_b32 s39, 1, 0
    s_cmp_eq_u32 s48, 1
    s_cbranch_scc1 L_jobq
    s_cmp_eq_u32 s80, 0
    s_cbranch_scc0 L_jobv
    s_waitcnt vmcnt(0)
    v_dot2_f32_bf16 v32, v16, v16, 0
    v_dot2_f32_bf16 v33, v17, v17, 0
    v_dot2_f32_bf16 v32, v18, v18, v32
    v_dot2_f32_bf16 v33, v19, v19, v33
    v_dot2_f32_bf16 v32, v20, v20, v32
    v_dot2_f32_bf16 v33, v21, v21, v33
    v_dot2_f32_bf16 v32, v22, v22, v32
    v_dot2_f32_bf16 v33, v23, v23, v33
    v_dot2_f32_bf16 v32, v24, v24, v32
    v_dot2_f32_bf16 v33, v25, v25, v33
    s_nop 2
    v_add_f32 v32, v32, v33
    v_sqrt_f32 v32, v32
    s_nop 0
    v_add_f32 v32, 0x358637bd, v32
    v_rcp_f32 v32, v32
    s_nop 0
    v_cvt_pk_bf16_f32 v33, v32, 0
    v_cvt_pk_bf16_f32 v40, 0, v32
    v_dot2_f32_bf16 v34, v16, v33, 0
    v_dot2_f32_bf16 v35, v16, v40, 0
    v_dot2_f32_bf16 v36, v17, v33, 0
    v_dot2_f32_bf16 v37, v17, v40, 0
    v_dot2_f32_bf16 v38, v18, v33, 0
    v_dot2_f32_bf16 v39, v18, v40, 0
    v_cvt_pk_bf16_f32 v16, v34, v35
    v_dot2_f32_bf16 v34, v19, v33, 0
    v_dot2_f32_bf16 v35, v19, v40, 0
    v_cvt_pk_bf16_f32 v17, v36, v37
    v_dot2_f32_bf16 v36, v20, v33, 0
    v_dot2_f32_bf16 v37, v20, v40, 0
    v_cvt_pk_bf16_f32 v18, v38, v39
    v_dot2_f32_bf16 v38, v21, v33, 0
    v_dot2_f32_bf16 v39, v21, v40, 0
    v_cvt_pk_bf16_f32 v19, v34, v35
    v_dot2_f32_bf16 v34, v22, v33, 0
    v_dot2_f32_bf16 v35, v22, v40, 0
    v_cvt_pk_bf16_f32 v20, v36, v37
    v_dot2_f32_bf16 v36, v23, v33, 0
    v_dot2_f32_bf16 v37, v23, v40, 0
    v_cvt_pk_bf16_f32 v21, v38, v39
    v_dot2_f32_bf16 v38, v24, v33, 0
    v_dot2_f32_bf16 v39, v24, v40, 0
    v_cvt_pk_bf16_f32 v22, v34, v35
    v_dot2_f32_bf16 v34, v25, v33, 0
    v_dot2_f32_bf16 v35, v25, v40, 0
    v_cvt_pk_bf16_f32 v23, v36, v37
    v_cvt_pk_bf16_f32 v24, v38, v39
    s_nop 1
    v_cvt_pk_bf16_f32 v25, v34, v35
    ds_write_b128 v107, v[16:19]
    ds_write_b128 v107, v[20:23] offset:512
    ds_write_b64 v124, v[24:25]
    v_add_u32 v107, s45, v107
    v_add_u32 v124, s45, v124
    s_branch L_jobdone
L_jobv:
    s_waitcnt vmcnt(0)
    ds_write_b128 v107, v[16:19]
    ds_write_b128 v107, v[20:23] offset:16
    ds_write2_b64 v107, v[24:25], v[120:121] offset0:4 offset1:5
    v_add_u32 v107, s45, v107
    v_add_u32 v124, s45, v124
    s_branch L_jobdone
L_jobq:
    s_and_b32 s28, s42, 7
    s_mul_i32 s28, s28, 3072
    s_add_u32 s28, s28, 98304
    v_lshl_add_u32 v9, v0, 4, s28
    v_lshl_add_u32 v10, v0, 3, s28
    s_and_b32 s29, s37, 0x80000000
    s_or_b32 s29, s29, 0x3f800000
    v_mov_b32 v98, s37
    v_mul_f32 v98, 0x3fb8aa3b, v98
    s_cmp_eq_u32 s39, 1
    s_cbranch_scc1 L_qprep
    v_mov_b32 v98, s29
L_qprep:
    v_add_u32 v8, s28, v108
    s_waitcnt vmcnt(0)
    ds_write_b128 v9, v[16:19]
    ds_write_b128 v9, v[20:23] offset:1024
    ds_write_b64 v10, v[24:25] offset:2048
    s_waitcnt lgkmcnt(0)
    ds_read2_b64 v[16:19], v8 offset0:0 offset1:1
    ds_read2_b64 v[20:23], v8 offset0:2 offset1:3
    ds_read_b64 v[24:25], v8 offset:32
    s_waitcnt lgkmcnt(0)
    v_dot2_f32_bf16 v32, v16, v16, 0
    v_dot2_f32_bf16 v33, v17, v17, 0
    v_dot2_f32_bf16 v32, v18, v18, v32
    v_dot2_f32_bf16 v33, v19, v19, v33
    v_dot2_f32_bf16 v32, v20, v20, v32
    v_dot2_f32_bf16 v33, v21, v21, v33
    v_dot2_f32_bf16 v32, v22, v22, v32
    v_dot2_f32_bf16 v33, v23, v23, v33
    v_dot2_f32_bf16 v32, v24, v24, v32
    v_dot2_f32_bf16 v33, v25, v25, v33
    s_nop 2
    v_add_f32 v32, v32, v33
    v_sqrt_f32 v32, v32
    s_nop 0
    v_add_f32 v32, 0x358637bd, v32
    v_rcp_f32 v32, v32
    s_nop 0
    v_mul_f32 v32, v32, v98
    v_cvt_pk_bf16_f32 v33, v32, 0
    v_cvt_pk_bf16_f32 v40, 0, v32
    v_dot2_f32_bf16 v34, v16, v33, 0
    v_dot2_f32_bf16 v35, v16, v40, 0
    v_dot2_f32_bf16 v36, v17, v33, 0
    v_dot2_f32_bf16 v37, v17, v40, 0
    v_dot2_f32_bf16 v38, v18, v33, 0
    v_dot2_f32_bf16 v39, v18, v40, 0
    v_cvt_pk_bf16_f32 v16, v34, v35
    v_dot2_f32_bf16 v34, v19, v33, 0
    v_dot2_f32_bf16 v35, v19, v40, 0
    v_cvt_pk_bf16_f32 v17, v36, v37
    v_dot2_f32_bf16 v36, v20, v33, 0
    v_dot2_f32_bf16 v37, v20, v40, 0
    v_cvt_pk_bf16_f32 v18, v38, v39
    v_dot2_f32_bf16 v38, v21, v33, 0
    v_dot2_f32_bf16 v39, v21, v40, 0
    v_cvt_pk_bf16_f32 v19, v34, v35
    v_dot2_f32_bf16 v34, v22, v33, 0
    v_dot2_f32_bf16 v35, v22, v40, 0
    v_cvt_pk_bf16_f32 v20, v36, v37
    v_dot2_f32_bf16 v36, v23, v33, 0
    v_dot2_f32_bf16 v37, v23, v40, 0
    v_cvt_pk_bf16_f32 v21, v38, v39
    v_dot2_f32_bf16 v38, v24, v33, 0
    v_dot2_f32_bf16 v39, v24, v40, 0
    v_cvt_pk_bf16_f32 v22, v34, v35
    v_dot2_f32_bf16 v34, v25, v33, 0
    v_dot2_f32_bf16 v35, v25, v40, 0
    v_cvt_pk_bf16_f32 v23, v36, v37
    v_cvt_pk_bf16_f32 v24, v38, v39
    s_nop 1
    v_cvt_pk_bf16_f32 v25, v34, v35
    s_nop 1
    v_permlane32_swap_b32 v16, v20
    v_permlane32_swap_b32 v17, v21
    v_permlane32_swap_b32 v18, v22
    v_permlane32_swap_b32 v19, v23
    ds_write_b64 v10, v[24:25] offset:2048
    s_nop 0
    ds_write_b128 v9, v[16:19]
    ds_write_b128 v9, v[20:23] offset:1024
L_jobdone:
    v_mov_b32 v2, 1
    s_waitcnt lgkmcnt(0)
    ds_write_b32 v96, v2
    v_mfma_f32_32x32x8_bf16 v[32:47], v[100:101], v[100:101], 0
L_poll:
    ds_read_b32 v3, v97
    s_waitcnt lgkmcnt(0)
    v_cmp_eq_u32 vcc, 1, v3
    s_and_b32 s28, vcc_lo, s35
    s_cmp_eq_u32 s28, s35
    s_cbranch_scc0 L_poll
    buffer_load_dwordx4 v[110:113], v108, s[20:23], s18 offen
    buffer_load_dwordx4 v[114:117], v108, s[20:23], s18 offen offset:16
    buffer_load_dwordx2 v[118:119], v108, s[20:23], s18 offen offset:32
    s_cmp_eq_u32 s39, 0
    s_cbranch_scc1 L_slow0
    ds_read_b64 v[94:95], v105 offset:13312
    ds_read_b64 v[88:89], v13 offset:2048
    ds_read_b128 v[90:93], v104 offset:12288
    ds_read_b128 v[84:87], v12
    ds_read_b128 v[80:83], v11
    s_mov_b32 s19, 0
    s_mov_b32 s41, 49152
    s_waitcnt lgkmcnt(3)
    v_mfma_f32_32x32x4_2b_bf16 v[0:31], v[94:95], v[88:89], 0
    ds_read_b64 v[94:95], v105 offset:16384
    ds_read_b64_tr_b16 v[96:97], v106 offset:12288
    ds_read_b64_tr_b16 v[98:99], v106 offset:12672
    s_setprio 2
    s_nop 7
    s_nop 7
    s_waitcnt lgkmcnt(4)
    v_mfma_f32_32x32x16_bf16 v[16:31], v[90:93], v[84:87], v[16:31]
    s_waitcnt lgkmcnt(3)
    v_mfma_f32_32x32x16_bf16 v[0:15], v[90:93], v[80:83], v[0:15]
    ds_read_b128 v[90:93], v104 offset:15360
    s_nop 7
    s_nop 1
    s_branch L_j4
    .p2align 6
L_loop:
    v_cvt_pk_bf16_f32 v42, v44, v45
    v_cvt_pk_bf16_f32 v43, v46, v47
    v_exp_f32 v16, v16
    v_exp_f32 v17, v17
    v_mfma_f32_32x32x16_bf16 v[64:79], v[100:103], v[40:43], v[64:79]
    ds_read_b64_tr_b16 v[100:101], v106 offset:768
    ds_read_b64_tr_b16 v[102:103], v106 offset:1152
    v_exp_f32 v18, v18
    v_exp_f32 v19, v19
    v_cvt_pk_bf16_f32 v16, v16, v17
    v_cvt_pk_bf16_f32 v17, v18, v19
    v_exp_f32 v20, v20
    v_exp_f32 v21, v21
    v_exp_f32 v22, v22
    v_exp_f32 v23, v23
    v_cvt_pk_bf16_f32 v18, v20, v21
    v_cvt_pk_bf16_f32 v19, v22, v23
    v_exp_f32 v24, v24
    v_exp_f32 v25, v25
    v_exp_f32 v26, v26
    v_exp_f32 v27, v27
    s_waitcnt lgkmcnt(3)
    v_mfma_f32_32x32x16_bf16 v[64:79], v[96:99], v[16:19], v[64:79]
    v_cvt_pk_bf16_f32 v24, v24, v25
    v_cvt_pk_bf16_f32 v25, v26, v27
    v_exp_f32 v28, v28
    v_exp_f32 v29, v29
    v_exp_f32 v30, v30
    v_exp_f32 v31, v31
    v_cvt_pk_bf16_f32 v26, v28, v29
    v_cvt_pk_bf16_f32 v27, v30, v31
    v_exp_f32 v0, v0
    v_exp_f32 v1, v1
    s_waitcnt lgkmcnt(0)
    v_mfma_f32_32x32x16_bf16 v[64:79], v[100:103], v[24:27], v[64:79]
    v_mfma_f32_32x32x4_2b_bf16 v[16:47], v[94:95], v[88:89], 0
    ds_read_b64 v[94:95], v105 offset:7168
    v_exp_f32 v2, v2
    v_exp_f32 v3, v3
    v_cvt_pk_bf16_f32 v0, v0, v1
    v_cvt_pk_bf16_f32 v1, v2, v3
    v_exp_f32 v4, v4
    v_exp_f32 v5, v5
    v_exp_f32 v6, v6
    v_exp_f32 v7, v7
    v_cvt_pk_bf16_f32 v2, v4, v5
    v_cvt_pk_bf16_f32 v3, v6, v7
    v_exp_f32 v8, v8
    v_exp_f32 v9, v9
    v_mfma_f32_32x32x16_bf16 v[16:31], v[90:93], v[80:83], v[16:31]
    v_exp_f32 v10, v10
    v_exp_f32 v11, v11
    v_cvt_pk_bf16_f32 v8, v8, v9
    v_cvt_pk_bf16_f32 v9, v10, v11
    v_mfma_f32_32x32x16_bf16 v[48:63], v[96:99], v[0:3], v[48:63]
    ds_read_b64_tr_b16 v[96:97], v106 offset:3072
    ds_read_b64_tr_b16 v[98:99], v106 offset:3456
    v_exp_f32 v12, v12
    v_exp_f32 v13, v13
    v_mfma_f32_32x32x16_bf16 v[32:47], v[90:93], v[84:87], v[32:47]
    ds_read_b128 v[90:93], v104 offset:6144
    v_exp_f32 v14, v14
    v_exp_f32 v15, v15
    v_cvt_pk_bf16_f32 v10, v12, v13
    v_cvt_pk_bf16_f32 v11, v14, v15
    v_exp_f32 v16, v16
    v_exp_f32 v17, v17
    v_mfma_f32_32x32x16_bf16 v[48:63], v[100:103], v[8:11], v[48:63]
    ds_read_b64_tr_b16 v[100:101], v106 offset:3840
    ds_read_b64_tr_b16 v[102:103], v106 offset:4224
    v_exp_f32 v18, v18
    v_exp_f32 v19, v19
    v_cvt_pk_bf16_f32 v16, v16, v17
    v_cvt_pk_bf16_f32 v17, v18, v19
    v_exp_f32 v20, v20
    v_exp_f32 v21, v21
    v_exp_f32 v22, v22
    v_exp_f32 v23, v23
    v_cvt_pk_bf16_f32 v18, v20, v21
    v_cvt_pk_bf16_f32 v19, v22, v23
    v_exp_f32 v24, v24
    v_exp_f32 v25, v25
    v_exp_f32 v26, v26
    v_exp_f32 v27, v27
    s_waitcnt lgkmcnt(3)
    v_mfma_f32_32x32x16_bf16 v[48:63], v[96:99], v[16:19], v[48:63]
    v_cvt_pk_bf16_f32 v24, v24, v25
    v_cvt_pk_bf16_f32 v25, v26, v27
    v_exp_f32 v28, v28
    v_exp_f32 v29, v29
    v_exp_f32 v30, v30
    v_exp_f32 v31, v31
    v_cvt_pk_bf16_f32 v26, v28, v29
    v_cvt_pk_bf16_f32 v27, v30, v31
    v_exp_f32 v32, v32
    v_exp_f32 v33, v33
    s_waitcnt lgkmcnt(0)
    v_mfma_f32_32x32x16_bf16 v[48:63], v[100:103], v[24:27], v[48:63]
    v_mfma_f32_32x32x4_2b_bf16 v[0:31], v[94:95], v[88:89], 0
    ds_read_b64 v[94:95], v105 offset:10240
    v_exp_f32 v34, v34
    v_exp_f32 v35, v35
    v_cvt_pk_bf16_f32 v32, v32, v33
    v_cvt_pk_bf16_f32 v33, v34, v35
    v_exp_f32 v36, v36
    v_exp_f32 v37, v37
    v_exp_f32 v38, v38
    v_exp_f32 v39, v39
    v_cvt_pk_bf16_f32 v34, v36, v37
    v_cvt_pk_bf16_f32 v35, v38, v39
    v_exp_f32 v40, v40
    v_exp_f32 v41, v41
    v_mfma_f32_32x32x16_bf16 v[16:31], v[90:93], v[84:87], v[16:31]
    v_exp_f32 v42, v42
    v_exp_f32 v43, v43
    v_cvt_pk_bf16_f32 v40, v40, v41
    v_cvt_pk_bf16_f32 v41, v42, v43
    v_mfma_f32_32x32x16_bf16 v[64:79], v[96:99], v[32:35], v[64:79]
    ds_read_b64_tr_b16 v[96:97], v106 offset:6144
    ds_read_b64_tr_b16 v[98:99], v106 offset:6528
    v_exp_f32 v44, v44
    v_exp_f32 v45, v45
    v_mfma_f32_32x32x16_bf16 v[0:15], v[90:93], v[80:83], v[0:15]
    ds_read_b128 v[90:93], v104 offset:9216
    v_exp_f32 v46, v46
    v_exp_f32 v47, v47
    v_cvt_pk_bf16_f32 v42, v44, v45
    v_cvt_pk_bf16_f32 v43, v46, v47
    v_exp_f32 v16, v16
    v_exp_f32 v17, v17
    v_mfma_f32_32x32x16_bf16 v[64:79], v[100:103], v[40:43], v[64:79]
    ds_read_b64_tr_b16 v[100:101], v106 offset:6912
    ds_read_b64_tr_b16 v[102:103], v106 offset:7296
    v_exp_f32 v18, v18
    v_exp_f32 v19, v19
    v_cvt_pk_bf16_f32 v16, v16, v17
    v_cvt_pk_bf16_f32 v17, v18, v19
    v_exp_f32 v20, v20
    v_exp_f32 v21, v21
    v_exp_f32 v22, v22
    v_exp_f32 v23, v23
    v_cvt_pk_bf16_f32 v18, v20, v21
    v_cvt_pk_bf16_f32 v19, v22, v23
    v_exp_f32 v24, v24
    v_exp_f32 v25, v25
    v_exp_f32 v26, v26
    v_exp_f32 v27, v27
    s_waitcnt lgkmcnt(3)
    v_mfma_f32_32x32x16_bf16 v[64:79], v[96:99], v[16:19], v[64:79]
    v_cvt_pk_bf16_f32 v24, v24, v25
    v_cvt_pk_bf16_f32 v25, v26, v27
    v_exp_f32 v28, v28
    v_exp_f32 v29, v29
    v_exp_f32 v30, v30
    v_exp_f32 v31, v31
    s_setprio 2
    v_cvt_pk_bf16_f32 v26, v28, v29
    v_cvt_pk_bf16_f32 v27, v30, v31
    v_exp_f32 v0, v0
    v_exp_f32 v1, v1
    s_waitcnt lgkmcnt(0)
    v_mfma_f32_32x32x16_bf16 v[64:79], v[100:103], v[24:27], v[64:79]
    v_mfma_f32_32x32x4_2b_bf16 v[16:47], v[94:95], v[88:89], 0
    ds_read_b64 v[94:95], v105 offset:13312
    v_exp_f32 v2, v2
    v_exp_f32 v3, v3
    v_cvt_pk_bf16_f32 v0, v0, v1
    v_cvt_pk_bf16_f32 v1, v2, v3
    v_exp_f32 v4, v4
    v_exp_f32 v5, v5
    v_exp_f32 v6, v6
    v_exp_f32 v7, v7
    v_cvt_pk_bf16_f32 v2, v4, v5
    v_cvt_pk_bf16_f32 v3, v6, v7
    v_exp_f32 v8, v8
    v_exp_f32 v9, v9
    v_mfma_f32_32x32x16_bf16 v[16:31], v[90:93], v[80:83], v[16:31]
    v_exp_f32 v10, v10
    v_exp_f32 v11, v11
    v_cvt_pk_bf16_f32 v8, v8, v9
    v_cvt_pk_bf16_f32 v9, v10, v11
    v_mfma_f32_32x32x16_bf16 v[48:63], v[96:99], v[0:3], v[48:63]
    ds_read_b64_tr_b16 v[96:97], v106 offset:9216
    ds_read_b64_tr_b16 v[98:99], v106 offset:9600
    v_exp_f32 v12, v12
    v_exp_f32 v13, v13
    v_mfma_f32_32x32x16_bf16 v[32:47], v[90:93], v[84:87], v[32:47]
    ds_read_b128 v[90:93], v104 offset:12288
    v_exp_f32 v14, v14
    v_exp_f32 v15, v15
    v_cvt_pk_bf16_f32 v10, v12, v13
    v_cvt_pk_bf16_f32 v11, v14, v15
    v_exp_f32 v16, v16
    v_exp_f32 v17, v17
    v_mfma_f32_32x32x16_bf16 v[48:63], v[100:103], v[8:11], v[48:63]
    ds_read_b64_tr_b16 v[100:101], v106 offset:9984
    ds_read_b64_tr_b16 v[102:103], v106 offset:10368
    s_cmp_eq_u32 s19, 0
    s_cbranch_scc1 L_noprep0
    s_cmp_eq_u32 s47, 0
    s_cbranch_scc1 L_noprep0
    s_waitcnt vmcnt(0)
    s_cmp_eq_u32 s80, 0
    s_cbranch_scc0 L_pv0
    v_dot2_f32_bf16 v0, v110, v110, 0
    v_dot2_f32_bf16 v1, v111, v111, 0
    v_dot2_f32_bf16 v0, v112, v112, v0
    v_dot2_f32_bf16 v1, v113, v113, v1
    v_dot2_f32_bf16 v0, v114, v114, v0
    v_dot2_f32_bf16 v1, v115, v115, v1
    v_dot2_f32_bf16 v0, v116, v116, v0
    v_dot2_f32_bf16 v1, v117, v117, v1
    v_dot2_f32_bf16 v0, v118, v118, v0
    v_dot2_f32_bf16 v1, v119, v119, v1
    s_nop 2
    v_add_f32 v0, v0, v1
    v_sqrt_f32 v0, v0
    s_nop 0
    v_add_f32 v0, 0x358637bd, v0
    v_rcp_f32 v0, v0
    s_nop 0
    v_cvt_pk_bf16_f32 v1, v0, 0
    v_cvt_pk_bf16_f32 v12, 0, v0
    v_dot2_f32_bf16 v2, v110, v1, 0
    v_dot2_f32_bf16 v3, v110, v12, 0
    v_dot2_f32_bf16 v4, v111, v1, 0
    v_dot2_f32_bf16 v5, v111, v12, 0
    v_dot2_f32_bf16 v6, v112, v1, 0
    v_dot2_f32_bf16 v7, v112, v12, 0
    v_cvt_pk_bf16_f32 v110, v2, v3
    v_dot2_f32_bf16 v2, v113, v1, 0
    v_dot2_f32_bf16 v3, v113, v12, 0
    v_cvt_pk_bf16_f32 v111, v4, v5
    v_dot2_f32_bf16 v4, v114, v1, 0
    v_dot2_f32_bf16 v5, v114, v12, 0
    v_cvt_pk_bf16_f32 v112, v6, v7
    v_dot2_f32_bf16 v6, v115, v1, 0
    v_dot2_f32_bf16 v7, v115, v12, 0
    v_cvt_pk_bf16_f32 v113, v2, v3
    v_dot2_f32_bf16 v2, v116, v1, 0
    v_dot2_f32_bf16 v3, v116, v12, 0
    v_cvt_pk_bf16_f32 v114, v4, v5
    v_dot2_f32_bf16 v4, v117, v1, 0
    v_dot2_f32_bf16 v5, v117, v12, 0
    v_cvt_pk_bf16_f32 v115, v6, v7
    v_dot2_f32_bf16 v6, v118, v1, 0
    v_dot2_f32_bf16 v7, v118, v12, 0
    v_cvt_pk_bf16_f32 v116, v2, v3
    v_dot2_f32_bf16 v2, v119, v1, 0
    v_dot2_f32_bf16 v3, v119, v12, 0
    v_cvt_pk_bf16_f32 v117, v4, v5
    v_cvt_pk_bf16_f32 v118, v6, v7
    s_nop 1
    v_cvt_pk_bf16_f32 v119, v2, v3
    ds_write_b128 v107, v[110:113]
    ds_write_b128 v107, v[114:117] offset:512
    ds_write_b64 v124, v[118:119]
    s_branch L_pdone0
L_pv0:
    ds_write_b128 v107, v[110:113]
    ds_write_b128 v107, v[114:117] offset:16
    ds_write_b128 v107, v[118:121] offset:32
L_pdone0:
    s_cmp_eq_u32 s19, 1
    s_cselect_b32 s28, s46, s45
    v_add_u32 v107, s28, v107
    v_add_u32 v124, s28, v124
    s_add_u32 s18, s18, 2560
    s_sub_u32 s47, s47, 1
    s_cmp_eq_u32 s47, 0
    s_waitcnt lgkmcnt(0)
    s_cbranch_scc1 L_noprep0
    buffer_load_dwordx4 v[110:113], v108, s[20:23], s18 offen
    buffer_load_dwordx4 v[114:117], v108, s[20:23], s18 offen offset:16
    buffer_load_dwordx2 v[118:119], v108, s[20:23], s18 offen offset:32
L_noprep0:
    v_exp_f32 v18, v18
    v_exp_f32 v19, v19
    v_cvt_pk_bf16_f32 v16, v16, v17
    v_cvt_pk_bf16_f32 v17, v18, v19
    v_exp_f32 v20, v20
    v_exp_f32 v21, v21
    v_exp_f32 v22, v22
    v_exp_f32 v23, v23
    v_cvt_pk_bf16_f32 v18, v20, v21
    v_cvt_pk_bf16_f32 v19, v22, v23
    v_exp_f32 v24, v24
    v_exp_f32 v25, v25
    v_exp_f32 v26, v26
    v_exp_f32 v27, v27
    s_waitcnt lgkmcnt(3)
    v_mfma_f32_32x32x16_bf16 v[48:63], v[96:99], v[16:19], v[48:63]
    v_cvt_pk_bf16_f32 v24, v24, v25
    v_cvt_pk_bf16_f32 v25, v26, v27
    v_exp_f32 v28, v28
    v_exp_f32 v29, v29
    v_exp_f32 v30, v30
    v_exp_f32 v31, v31
    v_cvt_pk_bf16_f32 v26, v28, v29
    v_cvt_pk_bf16_f32 v27, v30, v31
    v_exp_f32 v32, v32
    v_exp_f32 v33, v33
    s_waitcnt lgkmcnt(0)
    v_mfma_f32_32x32x16_bf16 v[48:63], v[100:103], v[24:27], v[48:63]
    v_mfma_f32_32x32x4_2b_bf16 v[0:31], v[94:95], v[88:89], 0
    ds_read_b64 v[94:95], v105 offset:16384
    v_exp_f32 v34, v34
    v_exp_f32 v35, v35
    v_cvt_pk_bf16_f32 v32, v32, v33
    v_cvt_pk_bf16_f32 v33, v34, v35
    v_exp_f32 v36, v36
    v_exp_f32 v37, v37
    v_exp_f32 v38, v38
    v_exp_f32 v39, v39
    v_cvt_pk_bf16_f32 v34, v36, v37
    v_cvt_pk_bf16_f32 v35, v38, v39
    v_exp_f32 v40, v40
    v_exp_f32 v41, v41
    v_mfma_f32_32x32x16_bf16 v[16:31], v[90:93], v[84:87], v[16:31]
    v_exp_f32 v42, v42
    v_exp_f32 v43, v43
    v_cvt_pk_bf16_f32 v40, v40, v41
    v_cvt_pk_bf16_f32 v41, v42, v43
    v_mfma_f32_32x32x16_bf16 v[64:79], v[96:99], v[32:35], v[64:79]
    ds_read_b64_tr_b16 v[96:97], v106 offset:12288
    ds_read_b64_tr_b16 v[98:99], v106 offset:12672
    v_exp_f32 v44, v44
    v_exp_f32 v45, v45
    v_mfma_f32_32x32x16_bf16 v[0:15], v[90:93], v[80:83], v[0:15]
    ds_read_b128 v[90:93], v104 offset:15360
    v_exp_f32 v46, v46
    v_exp_f32 v47, v47
L_j4:
    v_cvt_pk_bf16_f32 v42, v44, v45
    v_cvt_pk_bf16_f32 v43, v46, v47
    v_exp_f32 v16, v16
    v_exp_f32 v17, v17
    v_mfma_f32_32x32x16_bf16 v[64:79], v[100:103], v[40:43], v[64:79]
    ds_read_b64_tr_b16 v[100:101], v106 offset:13056
    ds_read_b64_tr_b16 v[102:103], v106 offset:13440
    v_exp_f32 v18, v18
    v_exp_f32 v19, v19
    v_cvt_pk_bf16_f32 v16, v16, v17
    v_cvt_pk_bf16_f32 v17, v18, v19
    v_exp_f32 v20, v20
    v_exp_f32 v21, v21
    v_exp_f32 v22, v22
    v_exp_f32 v23, v23
    v_cvt_pk_bf16_f32 v18, v20, v21
    v_cvt_pk_bf16_f32 v19, v22, v23
    v_exp_f32 v24, v24
    v_exp_f32 v25, v25
    v_exp_f32 v26, v26
    v_exp_f32 v27, v27
    s_waitcnt lgkmcnt(3)
    v_mfma_f32_32x32x16_bf16 v[64:79], v[96:99], v[16:19], v[64:79]
    v_cvt_pk_bf16_f32 v24, v24, v25
    v_cvt_pk_bf16_f32 v25, v26, v27
    v_exp_f32 v28, v28
    v_exp_f32 v29, v29
    v_exp_f32 v30, v30
    v_exp_f32 v31, v31
    v_cvt_pk_bf16_f32 v26, v28, v29
    v_cvt_pk_bf16_f32 v27, v30, v31
    v_exp_f32 v0, v0
    v_exp_f32 v1, v1
    s_waitcnt lgkmcnt(0)
    v_mfma_f32_32x32x16_bf16 v[64:79], v[100:103], v[24:27], v[64:79]
    v_mfma_f32_32x32x4_2b_bf16 v[16:47], v[94:95], v[88:89], 0
    ds_read_b64 v[94:95], v105 offset:19456
    v_exp_f32 v2, v2
    v_exp_f32 v3, v3
    v_cvt_pk_bf16_f32 v0, v0, v1
    v_cvt_pk_bf16_f32 v1, v2, v3
    v_exp_f32 v4, v4
    v_exp_f32 v5, v5
    v_exp_f32 v6, v6
    v_exp_f32 v7, v7
    v_cvt_pk_bf16_f32 v2, v4, v5
    v_cvt_pk_bf16_f32 v3, v6, v7
    v_exp_f32 v8, v8
    v_exp_f32 v9, v9
    v_mfma_f32_32x32x16_bf16 v[16:31], v[90:93], v[80:83], v[16:31]
    v_exp_f32 v10, v10
    v_exp_f32 v11, v11
    v_cvt_pk_bf16_f32 v8, v8, v9
    v_cvt_pk_bf16_f32 v9, v10, v11
    v_mfma_f32_32x32x16_bf16 v[48:63], v[96:99], v[0:3], v[48:63]
    ds_read_b64_tr_b16 v[96:97], v106 offset:15360
    ds_read_b64_tr_b16 v[98:99], v106 offset:15744
    v_exp_f32 v12, v12
    v_exp_f32 v13, v13
    v_mfma_f32_32x32x16_bf16 v[32:47], v[90:93], v[84:87], v[32:47]
    ds_read_b128 v[90:93], v104 offset:18432
    v_exp_f32 v14, v14
    v_exp_f32 v15, v15
    s_setprio 1
    v_cvt_pk_bf16_f32 v10, v12, v13
    v_cvt_pk_bf16_f32 v11, v14, v15
    v_exp_f32 v16, v16
    v_exp_f32 v17, v17
    v_mfma_f32_32x32x16_bf16 v[48:63], v[100:103], v[8:11], v[48:63]
    ds_read_b64_tr_b16 v[100:101], v106 offset:16128
    ds_read_b64_tr_b16 v[102:103], v106 offset:16512
    s_cmp_eq_u32 s19, 0
    s_cbranch_scc0 L_noprep1
    s_waitcnt vmcnt(0)
    s_cmp_eq_u32 s80, 0
    s_cbranch_scc0 L_pv1
    v_dot2_f32_bf16 v0, v110, v110, 0
    v_dot2_f32_bf16 v1, v111, v111, 0
    v_dot2_f32_bf16 v0, v112, v112, v0
    v_dot2_f32_bf16 v1, v113, v113, v1
    v_dot2_f32_bf16 v0, v114, v114, v0
    v_dot2_f32_bf16 v1, v115, v115, v1
    v_dot2_f32_bf16 v0, v116, v116, v0
    v_dot2_f32_bf16 v1, v117, v117, v1
    v_dot2_f32_bf16 v0, v118, v118, v0
    v_dot2_f32_bf16 v1, v119, v119, v1
    s_nop 2
    v_add_f32 v0, v0, v1
    v_sqrt_f32 v0, v0
    s_nop 0
    v_add_f32 v0, 0x358637bd, v0
    v_rcp_f32 v0, v0
    s_nop 0
    v_cvt_pk_bf16_f32 v1, v0, 0
    v_cvt_pk_bf16_f32 v12, 0, v0
    v_dot2_f32_bf16 v2, v110, v1, 0
    v_dot2_f32_bf16 v3, v110, v12, 0
    v_dot2_f32_bf16 v4, v111, v1, 0
    v_dot2_f32_bf16 v5, v111, v12, 0
    v_dot2_f32_bf16 v6, v112, v1, 0
    v_dot2_f32_bf16 v7, v112, v12, 0
    v_cvt_pk_bf16_f32 v110, v2, v3
    v_dot2_f32_bf16 v2, v113, v1, 0
    v_dot2_f32_bf16 v3, v113, v12, 0
    v_cvt_pk_bf16_f32 v111, v4, v5
    v_dot2_f32_bf16 v4, v114, v1, 0
    v_dot2_f32_bf16 v5, v114, v12, 0
    v_cvt_pk_bf16_f32 v112, v6, v7
    v_dot2_f32_bf16 v6, v115, v1, 0
    v_dot2_f32_bf16 v7, v115, v12, 0
    v_cvt_pk_bf16_f32 v113, v2, v3
    v_dot2_f32_bf16 v2, v116, v1, 0
    v_dot2_f32_bf16 v3, v116, v12, 0
    v_cvt_pk_bf16_f32 v114, v4, v5
    v_dot2_f32_bf16 v4, v117, v1, 0
    v_dot2_f32_bf16 v5, v117, v12, 0
    v_cvt_pk_bf16_f32 v115, v6, v7
    v_dot2_f32_bf16 v6, v118, v1, 0
    v_dot2_f32_bf16 v7, v118, v12, 0
    v_cvt_pk_bf16_f32 v116, v2, v3
    v_dot2_f32_bf16 v2, v119, v1, 0
    v_dot2_f32_bf16 v3, v119, v12, 0
    v_cvt_pk_bf16_f32 v117, v4, v5
    v_cvt_pk_bf16_f32 v118, v6, v7
    s_nop 1
    v_cvt_pk_bf16_f32 v119, v2, v3
    ds_write_b128 v107, v[110:113]
    ds_write_b128 v107, v[114:117] offset:512
    ds_write_b64 v124, v[118:119]
    s_branch L_pdone1
L_pv1:
    ds_write_b128 v107, v[110:113]
    ds_write_b128 v107, v[114:117] offset:16
    ds_write_b128 v107, v[118:121] offset:32
L_pdone1:
    s_cmp_eq_u32 s19, 1
    s_cselect_b32 s28, s46, s45
    v_add_u32 v107, s28, v107
    v_add_u32 v124, s28, v124
    s_add_u32 s18, s18, 2560
    s_sub_u32 s47, s47, 1
    s_cmp_eq_u32 s47, 0
    s_waitcnt lgkmcnt(0)
    s_cbranch_scc1 L_noprep1
    buffer_load_dwordx4 v[110:113], v108, s[20:23], s18 offen
    buffer_load_dwordx4 v[114:117], v108, s[20:23], s18 offen offset:16
    buffer_load_dwordx2 v[118:119], v108, s[20:23], s18 offen offset:32
L_noprep1:
    v_exp_f32 v18, v18
    v_exp_f32 v19, v19
    v_cvt_pk_bf16_f32 v16, v16, v17
    v_cvt_pk_bf16_f32 v17, v18, v19
    v_exp_f32 v20, v20
    v_exp_f32 v21, v21
    v_exp_f32 v22, v22
    v_exp_f32 v23, v23
    v_cvt_pk_bf16_f32 v18, v20, v21
    v_cvt_pk_bf16_f32 v19, v22, v23
    v_exp_f32 v24, v24
    v_exp_f32 v25, v25
    v_exp_f32 v26, v26
    v_exp_f32 v27, v27
    s_waitcnt lgkmcnt(3)
    v_mfma_f32_32x32x16_bf16 v[48:63], v[96:99], v[16:19], v[48:63]
    v_cvt_pk_bf16_f32 v24, v24, v25
    v_cvt_pk_bf16_f32 v25, v26, v27
    v_exp_f32 v28, v28
    v_exp_f32 v29, v29
    v_exp_f32 v30, v30
    v_exp_f32 v31, v31
    v_cvt_pk_bf16_f32 v26, v28, v29
    v_cvt_pk_bf16_f32 v27, v30, v31
    v_exp_f32 v32, v32
    v_exp_f32 v33, v33
    s_waitcnt lgkmcnt(0)
    v_mfma_f32_32x32x16_bf16 v[48:63], v[100:103], v[24:27], v[48:63]
    v_mfma_f32_32x32x4_2b_bf16 v[0:31], v[94:95], v[88:89], 0
    ds_read_b64 v[94:95], v105 offset:22528
    v_exp_f32 v34, v34
    v_exp_f32 v35, v35
    v_cvt_pk_bf16_f32 v32, v32, v33
    v_cvt_pk_bf16_f32 v33, v34, v35
    v_exp_f32 v36, v36
    v_exp_f32 v37, v37
    v_exp_f32 v38, v38
    v_exp_f32 v39, v39
    v_cvt_pk_bf16_f32 v34, v36, v37
    v_cvt_pk_bf16_f32 v35, v38, v39
    v_exp_f32 v40, v40
    v_exp_f32 v41, v41
    v_mfma_f32_32x32x16_bf16 v[16:31], v[90:93], v[84:87], v[16:31]
    v_exp_f32 v42, v42
    v_exp_f32 v43, v43
    v_cvt_pk_bf16_f32 v40, v40, v41
    v_cvt_pk_bf16_f32 v41, v42, v43
    v_mfma_f32_32x32x16_bf16 v[64:79], v[96:99], v[32:35], v[64:79]
    ds_read_b64_tr_b16 v[96:97], v106 offset:18432
    ds_read_b64_tr_b16 v[98:99], v106 offset:18816
    v_exp_f32 v44, v44
    v_exp_f32 v45, v45
    v_mfma_f32_32x32x16_bf16 v[0:15], v[90:93], v[80:83], v[0:15]
    ds_read_b128 v[90:93], v104 offset:21504
    v_exp_f32 v46, v46
    v_exp_f32 v47, v47
    v_cvt_pk_bf16_f32 v42, v44, v45
    v_cvt_pk_bf16_f32 v43, v46, v47
    v_exp_f32 v16, v16
    v_exp_f32 v17, v17
    v_mfma_f32_32x32x16_bf16 v[64:79], v[100:103], v[40:43], v[64:79]
    ds_read_b64_tr_b16 v[100:101], v106 offset:19200
    ds_read_b64_tr_b16 v[102:103], v106 offset:19584
    v_exp_f32 v18, v18
    v_exp_f32 v19, v19
    v_cvt_pk_bf16_f32 v16, v16, v17
    v_cvt_pk_bf16_f32 v17, v18, v19
    v_exp_f32 v20, v20
    v_exp_f32 v21, v21
    v_exp_f32 v22, v22
    v_exp_f32 v23, v23
    v_cvt_pk_bf16_f32 v18, v20, v21
    v_cvt_pk_bf16_f32 v19, v22, v23
    v_exp_f32 v24, v24
    v_exp_f32 v25, v25
    v_exp_f32 v26, v26
    v_exp_f32 v27, v27
    s_waitcnt lgkmcnt(3)
    v_mfma_f32_32x32x16_bf16 v[64:79], v[96:99], v[16:19], v[64:79]
    v_cvt_pk_bf16_f32 v24, v24, v25
    v_cvt_pk_bf16_f32 v25, v26, v27
    v_exp_f32 v28, v28
    v_exp_f32 v29, v29
    v_exp_f32 v30, v30
    v_exp_f32 v31, v31
    s_setprio 0
    v_cvt_pk_bf16_f32 v26, v28, v29
    v_cvt_pk_bf16_f32 v27, v30, v31
    v_exp_f32 v0, v0
    v_exp_f32 v1, v1
    s_waitcnt lgkmcnt(0)
    v_mfma_f32_32x32x16_bf16 v[64:79], v[100:103], v[24:27], v[64:79]
    v_mfma_f32_32x32x4_2b_bf16 v[16:47], v[94:95], v[88:89], 0
    v_exp_f32 v2, v2
    v_exp_f32 v3, v3
    v_cvt_pk_bf16_f32 v0, v0, v1
    v_cvt_pk_bf16_f32 v1, v2, v3
    v_exp_f32 v4, v4
    v_exp_f32 v5, v5
    v_exp_f32 v6, v6
    v_exp_f32 v7, v7
    v_cvt_pk_bf16_f32 v2, v4, v5
    v_cvt_pk_bf16_f32 v3, v6, v7
    v_exp_f32 v8, v8
    v_exp_f32 v9, v9
    v_mfma_f32_32x32x16_bf16 v[16:31], v[90:93], v[80:83], v[16:31]
    v_exp_f32 v10, v10
    v_exp_f32 v11, v11
    v_cvt_pk_bf16_f32 v8, v8, v9
    v_cvt_pk_bf16_f32 v9, v10, v11
    v_mfma_f32_32x32x16_bf16 v[48:63], v[96:99], v[0:3], v[48:63]
    ds_read_b64_tr_b16 v[96:97], v106 offset:21504
    ds_read_b64_tr_b16 v[98:99], v106 offset:21888
    v_exp_f32 v12, v12
    v_exp_f32 v13, v13
    v_mfma_f32_32x32x16_bf16 v[32:47], v[90:93], v[84:87], v[32:47]
    v_exp_f32 v14, v14
    v_exp_f32 v15, v15
    v_cvt_pk_bf16_f32 v10, v12, v13
    v_cvt_pk_bf16_f32 v11, v14, v15
    v_exp_f32 v16, v16
    v_exp_f32 v17, v17
    v_mfma_f32_32x32x16_bf16 v[48:63], v[100:103], v[8:11], v[48:63]
    ds_read_b64_tr_b16 v[100:101], v106 offset:22272
    ds_read_b64_tr_b16 v[102:103], v106 offset:22656
    v_exp_f32 v18, v18
    v_exp_f32 v19, v19
    s_barrier
    s_setprio 3
    v_add_u32 v104, s41, v104
    v_add_u32 v105, s41, v105
    ds_read_b64 v[94:95], v105 offset:1024
    ds_read_b128 v[90:93], v104 offset:0
    v_cvt_pk_bf16_f32 v16, v16, v17
    v_cvt_pk_bf16_f32 v17, v18, v19
    v_exp_f32 v20, v20
    v_exp_f32 v21, v21
    v_exp_f32 v22, v22
    v_exp_f32 v23, v23
    v_cvt_pk_bf16_f32 v18, v20, v21
    v_cvt_pk_bf16_f32 v19, v22, v23
    v_exp_f32 v24, v24
    v_exp_f32 v25, v25
    v_exp_f32 v26, v26
    v_exp_f32 v27, v27
    s_waitcnt lgkmcnt(4)
    v_mfma_f32_32x32x16_bf16 v[48:63], v[96:99], v[16:19], v[48:63]
    v_cvt_pk_bf16_f32 v24, v24, v25
    v_cvt_pk_bf16_f32 v25, v26, v27
    v_exp_f32 v28, v28
    v_exp_f32 v29, v29
    v_exp_f32 v30, v30
    v_exp_f32 v31, v31
    v_cvt_pk_bf16_f32 v26, v28, v29
    v_cvt_pk_bf16_f32 v27, v30, v31
    v_exp_f32 v32, v32
    v_exp_f32 v33, v33
    s_waitcnt lgkmcnt(2)
    v_mfma_f32_32x32x16_bf16 v[48:63], v[100:103], v[24:27], v[48:63]
    s_waitcnt lgkmcnt(1)
    v_mfma_f32_32x32x4_2b_bf16 v[0:31], v[94:95], v[88:89], 0
    ds_read_b64 v[94:95], v105 offset:4096
    v_exp_f32 v34, v34
    v_exp_f32 v35, v35
    v_cvt_pk_bf16_f32 v32, v32, v33
    v_cvt_pk_bf16_f32 v33, v34, v35
    v_exp_f32 v36, v36
    v_exp_f32 v37, v37
    v_exp_f32 v38, v38
    v_exp_f32 v39, v39
    v_cvt_pk_bf16_f32 v34, v36, v37
    v_cvt_pk_bf16_f32 v35, v38, v39
    v_exp_f32 v40, v40
    v_exp_f32 v41, v41
    s_waitcnt lgkmcnt(1)
    v_mfma_f32_32x32x16_bf16 v[16:31], v[90:93], v[84:87], v[16:31]
    v_exp_f32 v42, v42
    v_exp_f32 v43, v43
    v_cvt_pk_bf16_f32 v40, v40, v41
    v_cvt_pk_bf16_f32 v41, v42, v43
    v_mfma_f32_32x32x16_bf16 v[64:79], v[96:99], v[32:35], v[64:79]
    v_add_u32 v106, s41, v106
    ds_read_b64_tr_b16 v[96:97], v106 offset:0
    ds_read_b64_tr_b16 v[98:99], v106 offset:384
    v_exp_f32 v44, v44
    v_exp_f32 v45, v45
    v_mfma_f32_32x32x16_bf16 v[0:15], v[90:93], v[80:83], v[0:15]
    ds_read_b128 v[90:93], v104 offset:3072
    v_exp_f32 v46, v46
    v_exp_f32 v47, v47
    s_cmp_eq_u32 s19, 1
    s_cselect_b32 s41, s46, s45
    s_add_u32 s19, s19, 1
    s_cmp_lt_u32 s19, 4
    s_cbranch_scc1 L_loop
    v_cvt_pk_bf16_f32 v42, v44, v45
    v_cvt_pk_bf16_f32 v43, v46, v47
    v_exp_f32 v16, v16
    v_exp_f32 v17, v17
    v_mfma_f32_32x32x16_bf16 v[64:79], v[100:103], v[40:43], v[64:79]
    ds_read_b64_tr_b16 v[100:101], v106 offset:768
    ds_read_b64_tr_b16 v[102:103], v106 offset:1152
    v_exp_f32 v18, v18
    v_exp_f32 v19, v19
    v_cvt_pk_bf16_f32 v16, v16, v17
    v_cvt_pk_bf16_f32 v17, v18, v19
    v_exp_f32 v20, v20
    v_exp_f32 v21, v21
    v_exp_f32 v22, v22
    v_exp_f32 v23, v23
    v_cvt_pk_bf16_f32 v18, v20, v21
    v_cvt_pk_bf16_f32 v19, v22, v23
    v_exp_f32 v24, v24
    v_exp_f32 v25, v25
    v_exp_f32 v26, v26
    v_exp_f32 v27, v27
    s_waitcnt lgkmcnt(3)
    v_mfma_f32_32x32x16_bf16 v[64:79], v[96:99], v[16:19], v[64:79]
    v_cvt_pk_bf16_f32 v24, v24, v25
    v_cvt_pk_bf16_f32 v25, v26, v27
    v_exp_f32 v28, v28
    v_exp_f32 v29, v29
    v_exp_f32 v30, v30
    v_exp_f32 v31, v31
    v_cvt_pk_bf16_f32 v26, v28, v29
    v_cvt_pk_bf16_f32 v27, v30, v31
    v_exp_f32 v0, v0
    v_exp_f32 v1, v1
    s_waitcnt lgkmcnt(0)
    v_mfma_f32_32x32x16_bf16 v[64:79], v[100:103], v[24:27], v[64:79]
    v_mfma_f32_32x32x4_2b_bf16 v[16:47], v[94:95], v[88:89], 0
    ds_read_b64 v[94:95], v105 offset:7168
    v_exp_f32 v2, v2
    v_exp_f32 v3, v3
    v_cvt_pk_bf16_f32 v0, v0, v1
    v_cvt_pk_bf16_f32 v1, v2, v3
    v_exp_f32 v4, v4
    v_exp_f32 v5, v5
    v_exp_f32 v6, v6
    v_exp_f32 v7, v7
    v_cvt_pk_bf16_f32 v2, v4, v5
    v_cvt_pk_bf16_f32 v3, v6, v7
    v_exp_f32 v8, v8
    v_exp_f32 v9, v9
    v_mfma_f32_32x32x16_bf16 v[16:31], v[90:93], v[80:83], v[16:31]
    v_exp_f32 v10, v10
    v_exp_f32 v11, v11
    v_cvt_pk_bf16_f32 v8, v8, v9
    v_cvt_pk_bf16_f32 v9, v10, v11
    v_mfma_f32_32x32x16_bf16 v[48:63], v[96:99], v[0:3], v[48:63]
    ds_read_b64_tr_b16 v[96:97], v106 offset:3072
    ds_read_b64_tr_b16 v[98:99], v106 offset:3456
    v_exp_f32 v12, v12
    v_exp_f32 v13, v13
    v_mfma_f32_32x32x16_bf16 v[32:47], v[90:93], v[84:87], v[32:47]
    ds_read_b128 v[90:93], v104 offset:6144
    v_exp_f32 v14, v14
    v_exp_f32 v15, v15
    s_setprio 2
    v_cvt_pk_bf16_f32 v10, v12, v13
    v_cvt_pk_bf16_f32 v11, v14, v15
    v_exp_f32 v16, v16
    v_exp_f32 v17, v17
    v_mfma_f32_32x32x16_bf16 v[48:63], v[100:103], v[8:11], v[48:63]
    ds_read_b64_tr_b16 v[100:101], v106 offset:3840
    ds_read_b64_tr_b16 v[102:103], v106 offset:4224
    v_exp_f32 v18, v18
    v_exp_f32 v19, v19
    v_cvt_pk_bf16_f32 v16, v16, v17
    v_cvt_pk_bf16_f32 v17, v18, v19
    v_exp_f32 v20, v20
    v_exp_f32 v21, v21
    v_exp_f32 v22, v22
    v_exp_f32 v23, v23
    v_cvt_pk_bf16_f32 v18, v20, v21
    v_cvt_pk_bf16_f32 v19, v22, v23
    v_exp_f32 v24, v24
    v_exp_f32 v25, v25
    v_exp_f32 v26, v26
    v_exp_f32 v27, v27
    s_waitcnt lgkmcnt(3)
    v_mfma_f32_32x32x16_bf16 v[48:63], v[96:99], v[16:19], v[48:63]
    v_cvt_pk_bf16_f32 v24, v24, v25
    v_cvt_pk_bf16_f32 v25, v26, v27
    v_exp_f32 v28, v28
    v_exp_f32 v29, v29
    v_exp_f32 v30, v30
    v_exp_f32 v31, v31
    v_cvt_pk_bf16_f32 v26, v28, v29
    v_cvt_pk_bf16_f32 v27, v30, v31
    v_exp_f32 v32, v32
    v_exp_f32 v33, v33
    s_waitcnt lgkmcnt(0)
    v_mfma_f32_32x32x16_bf16 v[48:63], v[100:103], v[24:27], v[48:63]
    v_mfma_f32_32x32x4_2b_bf16 v[0:31], v[94:95], v[88:89], 0
    ds_read_b64 v[94:95], v105 offset:10240
    v_exp_f32 v34, v34
    v_exp_f32 v35, v35
    v_cvt_pk_bf16_f32 v32, v32, v33
    v_cvt_pk_bf16_f32 v33, v34, v35
    v_exp_f32 v36, v36
    v_exp_f32 v37, v37
    v_exp_f32 v38, v38
    v_exp_f32 v39, v39
    v_cvt_pk_bf16_f32 v34, v36, v37
    v_cvt_pk_bf16_f32 v35, v38, v39
    v_exp_f32 v40, v40
    v_exp_f32 v41, v41
    v_mfma_f32_32x32x16_bf16 v[16:31], v[90:93], v[84:87], v[16:31]
    v_exp_f32 v42, v42
    v_exp_f32 v43, v43
    v_cvt_pk_bf16_f32 v40, v40, v41
    v_cvt_pk_bf16_f32 v41, v42, v43
    v_mfma_f32_32x32x16_bf16 v[64:79], v[96:99], v[32:35], v[64:79]
    ds_read_b64_tr_b16 v[96:97], v106 offset:6144
    ds_read_b64_tr_b16 v[98:99], v106 offset:6528
    v_exp_f32 v44, v44
    v_exp_f32 v45, v45
    v_mfma_f32_32x32x16_bf16 v[0:15], v[90:93], v[80:83], v[0:15]
    ds_read_b128 v[90:93], v104 offset:9216
    v_exp_f32 v46, v46
    v_exp_f32 v47, v47
    v_cvt_pk_bf16_f32 v42, v44, v45
    v_cvt_pk_bf16_f32 v43, v46, v47
    v_exp_f32 v16, v16
    v_exp_f32 v17, v17
    v_mfma_f32_32x32x16_bf16 v[64:79], v[100:103], v[40:43], v[64:79]
    ds_read_b64_tr_b16 v[100:101], v106 offset:6912
    ds_read_b64_tr_b16 v[102:103], v106 offset:7296
    v_exp_f32 v18, v18
    v_exp_f32 v19, v19
    v_cvt_pk_bf16_f32 v16, v16, v17
    v_cvt_pk_bf16_f32 v17, v18, v19
    v_exp_f32 v20, v20
    v_exp_f32 v21, v21
    v_exp_f32 v22, v22
    v_exp_f32 v23, v23
    v_cvt_pk_bf16_f32 v18, v20, v21
    v_cvt_pk_bf16_f32 v19, v22, v23
    v_exp_f32 v24, v24
    v_exp_f32 v25, v25
    v_exp_f32 v26, v26
    v_exp_f32 v27, v27
    s_waitcnt lgkmcnt(3)
    v_mfma_f32_32x32x16_bf16 v[64:79], v[96:99], v[16:19], v[64:79]
    v_cvt_pk_bf16_f32 v24, v24, v25
    v_cvt_pk_bf16_f32 v25, v26, v27
    v_exp_f32 v28, v28
    v_exp_f32 v29, v29
    v_exp_f32 v30, v30
    v_exp_f32 v31, v31
    s_setprio 1
    v_cvt_pk_bf16_f32 v26, v28, v29
    v_cvt_pk_bf16_f32 v27, v30, v31
    v_exp_f32 v0, v0
    v_exp_f32 v1, v1
    s_waitcnt lgkmcnt(0)
    v_mfma_f32_32x32x16_bf16 v[64:79], v[100:103], v[24:27], v[64:79]
    v_mfma_f32_32x32x4_2b_bf16 v[16:47], v[94:95], v[88:89], 0
    v_exp_f32 v2, v2
    v_exp_f32 v3, v3
    v_cvt_pk_bf16_f32 v0, v0, v1
    v_cvt_pk_bf16_f32 v1, v2, v3
    v_exp_f32 v4, v4
    v_exp_f32 v5, v5
    v_exp_f32 v6, v6
    v_exp_f32 v7, v7
    v_cvt_pk_bf16_f32 v2, v4, v5
    v_cvt_pk_bf16_f32 v3, v6, v7
    v_exp_f32 v8, v8
    v_exp_f32 v9, v9
    v_mfma_f32_32x32x16_bf16 v[16:31], v[90:93], v[80:83], v[16:31]
    v_exp_f32 v10, v10
    v_exp_f32 v11, v11
    v_cvt_pk_bf16_f32 v8, v8, v9
    v_cvt_pk_bf16_f32 v9, v10, v11
    v_mfma_f32_32x32x16_bf16 v[48:63], v[96:99], v[0:3], v[48:63]
    ds_read_b64_tr_b16 v[96:97], v106 offset:9216
    ds_read_b64_tr_b16 v[98:99], v106 offset:9600
    v_exp_f32 v12, v12
    v_exp_f32 v13, v13
    v_mfma_f32_32x32x16_bf16 v[32:47], v[90:93], v[84:87], v[32:47]
    v_exp_f32 v14, v14
    v_exp_f32 v15, v15
    v_cvt_pk_bf16_f32 v10, v12, v13
    v_cvt_pk_bf16_f32 v11, v14, v15
    v_exp_f32 v16, v16
    v_exp_f32 v17, v17
    v_mfma_f32_32x32x16_bf16 v[48:63], v[100:103], v[8:11], v[48:63]
    ds_read_b64_tr_b16 v[100:101], v106 offset:9984
    ds_read_b64_tr_b16 v[102:103], v106 offset:10368
    v_exp_f32 v18, v18
    v_exp_f32 v19, v19
    v_cvt_pk_bf16_f32 v16, v16, v17
    v_cvt_pk_bf16_f32 v17, v18, v19
    v_exp_f32 v20, v20
    v_exp_f32 v21, v21
    v_exp_f32 v22, v22
    v_exp_f32 v23, v23
    v_cvt_pk_bf16_f32 v18, v20, v21
    v_cvt_pk_bf16_f32 v19, v22, v23
    v_exp_f32 v24, v24
    v_exp_f32 v25, v25
    v_exp_f32 v26, v26
    v_exp_f32 v27, v27
    s_waitcnt lgkmcnt(2)
    v_mfma_f32_32x32x16_bf16 v[48:63], v[96:99], v[16:19], v[48:63]
    v_cvt_pk_bf16_f32 v24, v24, v25
    v_cvt_pk_bf16_f32 v25, v26, v27
    v_exp_f32 v28, v28
    v_exp_f32 v29, v29
    v_exp_f32 v30, v30
    v_exp_f32 v31, v31
    s_setprio 0
    v_cvt_pk_bf16_f32 v26, v28, v29
    v_cvt_pk_bf16_f32 v27, v30, v31
    v_exp_f32 v32, v32
    v_exp_f32 v33, v33
    s_waitcnt lgkmcnt(0)
    v_mfma_f32_32x32x16_bf16 v[48:63], v[100:103], v[24:27], v[48:63]
    v_exp_f32 v34, v34
    v_exp_f32 v35, v35
    v_cvt_pk_bf16_f32 v32, v32, v33
    v_cvt_pk_bf16_f32 v33, v34, v35
    v_exp_f32 v36, v36
    v_exp_f32 v37, v37
    v_exp_f32 v38, v38
    v_exp_f32 v39, v39
    v_cvt_pk_bf16_f32 v34, v36, v37
    v_cvt_pk_bf16_f32 v35, v38, v39
    v_exp_f32 v40, v40
    v_exp_f32 v41, v41
    v_exp_f32 v42, v42
    v_exp_f32 v43, v43
    v_cvt_pk_bf16_f32 v40, v40, v41
    v_cvt_pk_bf16_f32 v41, v42, v43
    v_mfma_f32_32x32x16_bf16 v[64:79], v[96:99], v[32:35], v[64:79]
    v_exp_f32 v44, v44
    v_exp_f32 v45, v45
    v_exp_f32 v46, v46
    v_exp_f32 v47, v47
    v_cvt_pk_bf16_f32 v42, v44, v45
    v_cvt_pk_bf16_f32 v43, v46, v47
    s_nop 1
    v_mfma_f32_32x32x16_bf16 v[64:79], v[100:103], v[40:43], v[64:79]
L_epi:
    s_nop 7
    s_nop 7
    ds_write_b128 v109, v[64:67]
    ds_write_b128 v109, v[68:71] offset:1024
    ds_write_b128 v109, v[72:75] offset:2048
    s_waitcnt lgkmcnt(0)
    s_barrier
    ds_read_b128 v[24:27], v122 offset:2048
    ds_read_b128 v[16:19], v122
    ds_read_b128 v[20:23], v122 offset:1024
    v_mbcnt_lo_u32_b32 v81, -1, 0
    v_mbcnt_hi_u32_b32 v81, -1, v81
    v_lshlrev_b32 v81, 4, v81
    v_sub_u32 v80, v122, v81
    v_add_u32 v80, v80, v123
    s_waitcnt lgkmcnt(2)
    v_add_f32 v28, v56, v24
    v_add_f32 v30, v56, v24
    v_pk_add_f32 v[56:57], v[56:57], v[24:25]
    v_pk_add_f32 v[58:59], v[58:59], v[26:27]
    v_permlane32_swap_b32 v28, v30
    s_waitcnt lgkmcnt(1)
    v_pk_add_f32 v[48:49], v[48:49], v[16:17]
    s_nop 0
    v_rcp_f32 v30, v30
    v_pk_add_f32 v[50:51], v[50:51], v[18:19]
    s_waitcnt lgkmcnt(0)
    v_pk_add_f32 v[52:53], v[52:53], v[20:21]
    v_pk_add_f32 v[54:55], v[54:55], v[22:23]
    v_pk_mul_f32 v[48:49], v[48:49], v[30:31] op_sel_hi:[1,0]
    v_pk_mul_f32 v[50:51], v[50:51], v[30:31] op_sel_hi:[1,0]
    v_pk_mul_f32 v[52:53], v[52:53], v[30:31] op_sel_hi:[1,0]
    v_pk_mul_f32 v[54:55], v[54:55], v[30:31] op_sel_hi:[1,0]
    v_pk_mul_f32 v[56:57], v[56:57], v[30:31] op_sel_hi:[1,0]
    v_pk_mul_f32 v[58:59], v[58:59], v[30:31] op_sel_hi:[1,0]
    v_cvt_pk_bf16_f32 v16, v48, v49
    v_cvt_pk_bf16_f32 v17, v50, v51
    v_cvt_pk_bf16_f32 v18, v52, v53
    v_cvt_pk_bf16_f32 v19, v54, v55
    v_cvt_pk_bf16_f32 v20, v56, v57
    v_cvt_pk_bf16_f32 v21, v58, v59
    v_permlane32_swap_b32 v16, v18
    v_permlane32_swap_b32 v17, v19
    s_nop 1
    ds_write2_b64 v80, v[16:17], v[18:19] offset0:0 offset1:1
    s_mov_b64 exec, 0xffffffff
    ds_write_b64 v80, v[20:21] offset:32
    s_mov_b64 exec, -1
    s_waitcnt lgkmcnt(0)
    ds_read_b128 v[24:27], v122
    ds_read_b128 v[28:31], v122 offset:1024
    s_waitcnt lgkmcnt(1)
    buffer_store_dwordx4 v[24:27], v81, s[84:87], s15 offen sc0 sc1 nt
    s_mov_b64 exec, 0xffff
    s_waitcnt lgkmcnt(0)
    buffer_store_dwordx4 v[28:31], v81, s[84:87], s15 offen offset:1024 sc0 sc1 nt
    s_endpgm
L_slow0:
    ds_read_b64 v[88:89], v13 offset:2048
    ds_read_b128 v[84:87], v12
    ds_read_b128 v[80:83], v11
    s_nop 7
    s_nop 7
    v_mov_b32 v42, 0xff800000
    v_mov_b32 v43, 0xff800000
    v_subrev_u32 v107, s45, v107
    v_subrev_u32 v124, s45, v124
    s_mov_b32 s44, 0
L_s_pass:
    s_mov_b32 s18, s34
    s_mov_b32 s19, 0
L_s_round:
    s_waitcnt vmcnt(0) lgkmcnt(0)
    s_barrier
    buffer_load_dwordx4 v[110:113], v108, s[20:23], s18 offen
    buffer_load_dwordx4 v[114:117], v108, s[20:23], s18 offen offset:16
    buffer_load_dwordx2 v[118:119], v108, s[20:23], s18 offen offset:32
    s_waitcnt vmcnt(0)
    s_cmp_eq_u32 s80, 0
    s_cbranch_scc0 L_s_pvw
    v_dot2_f32_bf16 v32, v110, v110, 0
    v_dot2_f32_bf16 v33, v111, v111, 0
    v_dot2_f32_bf16 v32, v112, v112, v32
    v_dot2_f32_bf16 v33, v113, v113, v33
    v_dot2_f32_bf16 v32, v114, v114, v32
    v_dot2_f32_bf16 v33, v115, v115, v33
    v_dot2_f32_bf16 v32, v116, v116, v32
    v_dot2_f32_bf16 v33, v117, v117, v33
    v_dot2_f32_bf16 v32, v118, v118, v32
    v_dot2_f32_bf16 v33, v119, v119, v33
    s_nop 2
    v_add_f32 v32, v32, v33
    v_sqrt_f32 v32, v32
    s_nop 0
    v_add_f32 v32, 0x358637bd, v32
    v_rcp_f32 v32, v32
    s_nop 0
    v_cvt_pk_bf16_f32 v33, v32, 0
    v_cvt_pk_bf16_f32 v40, 0, v32
    v_dot2_f32_bf16 v34, v110, v33, 0
    v_dot2_f32_bf16 v35, v110, v40, 0
    v_dot2_f32_bf16 v36, v111, v33, 0
    v_dot2_f32_bf16 v37, v111, v40, 0
    v_dot2_f32_bf16 v38, v112, v33, 0
    v_dot2_f32_bf16 v39, v112, v40, 0
    v_cvt_pk_bf16_f32 v110, v34, v35
    v_dot2_f32_bf16 v34, v113, v33, 0
    v_dot2_f32_bf16 v35, v113, v40, 0
    v_cvt_pk_bf16_f32 v111, v36, v37
    v_dot2_f32_bf16 v36, v114, v33, 0
    v_dot2_f32_bf16 v37, v114, v40, 0
    v_cvt_pk_bf16_f32 v112, v38, v39
    v_dot2_f32_bf16 v38, v115, v33, 0
    v_dot2_f32_bf16 v39, v115, v40, 0
    v_cvt_pk_bf16_f32 v113, v34, v35
    v_dot2_f32_bf16 v34, v116, v33, 0
    v_dot2_f32_bf16 v35, v116, v40, 0
    v_cvt_pk_bf16_f32 v114, v36, v37
    v_dot2_f32_bf16 v36, v117, v33, 0
    v_dot2_f32_bf16 v37, v117, v40, 0
    v_cvt_pk_bf16_f32 v115, v38, v39
    v_dot2_f32_bf16 v38, v118, v33, 0
    v_dot2_f32_bf16 v39, v118, v40, 0
    v_cvt_pk_bf16_f32 v116, v34, v35
    v_dot2_f32_bf16 v34, v119, v33, 0
    v_dot2_f32_bf16 v35, v119, v40, 0
    v_cvt_pk_bf16_f32 v117, v36, v37
    v_cvt_pk_bf16_f32 v118, v38, v39
    s_nop 1
    v_cvt_pk_bf16_f32 v119, v34, v35
    ds_write_b128 v107, v[110:113]
    ds_write_b128 v107, v[114:117] offset:512
    ds_write_b64 v124, v[118:119]
    s_branch L_s_pdone
L_s_pvw:
    ds_write_b128 v107, v[110:113]
    ds_write_b128 v107, v[114:117] offset:16
    ds_write_b128 v107, v[118:121] offset:32
L_s_pdone:
    s_waitcnt lgkmcnt(0)
    s_barrier
    s_mov_b32 s43, 0
L_s_tile:
    ds_read_b128 v[90:93], v104 offset:0
    ds_read_b64 v[94:95], v105 offset:1024
    ds_read_b64_tr_b16 v[96:97], v106 offset:0
    ds_read_b64_tr_b16 v[98:99], v106 offset:384
    ds_read_b64_tr_b16 v[100:101], v106 offset:768
    ds_read_b64_tr_b16 v[102:103], v106 offset:1152
    s_waitcnt lgkmcnt(0)
    v_mfma_f32_32x32x4_2b_bf16 v[0:31], v[94:95], v[88:89], 0
    s_nop 7
    s_nop 7
    s_nop 3
    v_mfma_f32_32x32x16_bf16 v[0:15], v[90:93], v[80:83], v[0:15]
    v_mfma_f32_32x32x16_bf16 v[16:31], v[90:93], v[84:87], v[16:31]
    s_nop 7
    s_nop 7
    s_cmp_eq_u32 s44, 1
    s_cbranch_scc1 L_s_pv
    v_max3_f32 v42, v0, v1, v42
    v_max3_f32 v43, v16, v17, v43
    v_max3_f32 v42, v2, v3, v42
    v_max3_f32 v43, v18, v19, v43
    v_max3_f32 v42, v4, v5, v42
    v_max3_f32 v43, v20, v21, v43
    v_max3_f32 v42, v6, v7, v42
    v_max3_f32 v43, v22, v23, v43
    v_max3_f32 v42, v8, v9, v42
    v_max3_f32 v43, v24, v25, v43
    v_max3_f32 v42, v10, v11, v42
    v_max3_f32 v43, v26, v27, v43
    v_max3_f32 v42, v12, v13, v42
    v_max3_f32 v43, v28, v29, v43
    v_max3_f32 v42, v14, v15, v42
    v_max3_f32 v43, v30, v31, v43
    s_branch L_s_next
L_s_pv:
    v_sub_f32 v0, v0, v42
    v_mul_f32 v0, s38, v0
    v_mul_f32 v0, 0x3fb8aa3b, v0
    v_exp_f32 v0, v0
    v_sub_f32 v1, v1, v42
    v_mul_f32 v1, s38, v1
    v_mul_f32 v1, 0x3fb8aa3b, v1
    v_exp_f32 v1, v1
    v_sub_f32 v2, v2, v42
    v_mul_f32 v2, s38, v2
    v_mul_f32 v2, 0x3fb8aa3b, v2
    v_exp_f32 v2, v2
    v_sub_f32 v3, v3, v42
    v_mul_f32 v3, s38, v3
    v_mul_f32 v3, 0x3fb8aa3b, v3
    v_exp_f32 v3, v3
    v_sub_f32 v4, v4, v42
    v_mul_f32 v4, s38, v4
    v_mul_f32 v4, 0x3fb8aa3b, v4
    v_exp_f32 v4, v4
    v_sub_f32 v5, v5, v42
    v_mul_f32 v5, s38, v5
    v_mul_f32 v5, 0x3fb8aa3b, v5
    v_exp_f32 v5, v5
    v_sub_f32 v6, v6, v42
    v_mul_f32 v6, s38, v6
    v_mul_f32 v6, 0x3fb8aa3b, v6
    v_exp_f32 v6, v6
    v_sub_f32 v7, v7, v42
    v_mul_f32 v7, s38, v7
    v_mul_f32 v7, 0x3fb8aa3b, v7
    v_exp_f32 v7, v7
    v_sub_f32 v8, v8, v42
    v_mul_f32 v8, s38, v8
    v_mul_f32 v8, 0x3fb8aa3b, v8
    v_exp_f32 v8, v8
    v_sub_f32 v9, v9, v42
    v_mul_f32 v9, s38, v9
    v_mul_f32 v9, 0x3fb8aa3b, v9
    v_exp_f32 v9, v9
    v_sub_f32 v10, v10, v42
    v_mul_f32 v10, s38, v10
    v_mul_f32 v10, 0x3fb8aa3b, v10
    v_exp_f32 v10, v10
    v_sub_f32 v11, v11, v42
    v_mul_f32 v11, s38, v11
    v_mul_f32 v11, 0x3fb8aa3b, v11
    v_exp_f32 v11, v11
    v_sub_f32 v12, v12, v42
    v_mul_f32 v12, s38, v12
    v_mul_f32 v12, 0x3fb8aa3b, v12
    v_exp_f32 v12, v12
    v_sub_f32 v13, v13, v42
    v_mul_f32 v13, s38, v13
    v_mul_f32 v13, 0x3fb8aa3b, v13
    v_exp_f32 v13, v13
    v_sub_f32 v14, v14, v42
    v_mul_f32 v14, s38, v14
    v_mul_f32 v14, 0x3fb8aa3b, v14
    v_exp_f32 v14, v14
    v_sub_f32 v15, v15, v42
    v_mul_f32 v15, s38, v15
    v_mul_f32 v15, 0x3fb8aa3b, v15
    v_exp_f32 v15, v15
    s_nop 0
    v_cvt_pk_bf16_f32 v0, v0, v1
    v_cvt_pk_bf16_f32 v1, v2, v3
    v_cvt_pk_bf16_f32 v2, v4, v5
    v_cvt_pk_bf16_f32 v3, v6, v7
    v_cvt_pk_bf16_f32 v8, v8, v9
    v_cvt_pk_bf16_f32 v9, v10, v11
    v_cvt_pk_bf16_f32 v10, v12, v13
    v_cvt_pk_bf16_f32 v11, v14, v15
    s_nop 1
    v_mfma_f32_32x32x16_bf16 v[48:63], v[96:99], v[0:3], v[48:63]
    v_mfma_f32_32x32x16_bf16 v[48:63], v[100:103], v[8:11], v[48:63]
    s_nop 7
    v_sub_f32 v16, v16, v43
    v_mul_f32 v16, s38, v16
    v_mul_f32 v16, 0x3fb8aa3b, v16
    v_exp_f32 v16, v16
    v_sub_f32 v17, v17, v43
    v_mul_f32 v17, s38, v17
    v_mul_f32 v17, 0x3fb8aa3b, v17
    v_exp_f32 v17, v17
    v_sub_f32 v18, v18, v43
    v_mul_f32 v18, s38, v18
    v_mul_f32 v18, 0x3fb8aa3b, v18
    v_exp_f32 v18, v18
    v_sub_f32 v19, v19, v43
    v_mul_f32 v19, s38, v19
    v_mul_f32 v19, 0x3fb8aa3b, v19
    v_exp_f32 v19, v19
    v_sub_f32 v20, v20, v43
    v_mul_f32 v20, s38, v20
    v_mul_f32 v20, 0x3fb8aa3b, v20
    v_exp_f32 v20, v20
    v_sub_f32 v21, v21, v43
    v_mul_f32 v21, s38, v21
    v_mul_f32 v21, 0x3fb8aa3b, v21
    v_exp_f32 v21, v21
    v_sub_f32 v22, v22, v43
    v_mul_f32 v22, s38, v22
    v_mul_f32 v22, 0x3fb8aa3b, v22
    v_exp_f32 v22, v22
    v_sub_f32 v23, v23, v43
    v_mul_f32 v23, s38, v23
    v_mul_f32 v23, 0x3fb8aa3b, v23
    v_exp_f32 v23, v23
    v_sub_f32 v24, v24, v43
    v_mul_f32 v24, s38, v24
    v_mul_f32 v24, 0x3fb8aa3b, v24
    v_exp_f32 v24, v24
    v_sub_f32 v25, v25, v43
    v_mul_f32 v25, s38, v25
    v_mul_f32 v25, 0x3fb8aa3b, v25
    v_exp_f32 v25, v25
    v_sub_f32 v26, v26, v43
    v_mul_f32 v26, s38, v26
    v_mul_f32 v26, 0x3fb8aa3b, v26
    v_exp_f32 v26, v26
    v_sub_f32 v27, v27, v43
    v_mul_f32 v27, s38, v27
    v_mul_f32 v27, 0x3fb8aa3b, v27
    v_exp_f32 v27, v27
    v_sub_f32 v28, v28, v43
    v_mul_f32 v28, s38, v28
    v_mul_f32 v28, 0x3fb8aa3b, v28
    v_exp_f32 v28, v28
    v_sub_f32 v29, v29, v43
    v_mul_f32 v29, s38, v29
    v_mul_f32 v29, 0x3fb8aa3b, v29
    v_exp_f32 v29, v29
    v_sub_f32 v30, v30, v43
    v_mul_f32 v30, s38, v30
    v_mul_f32 v30, 0x3fb8aa3b, v30
    v_exp_f32 v30, v30
    v_sub_f32 v31, v31, v43
    v_mul_f32 v31, s38, v31
    v_mul_f32 v31, 0x3fb8aa3b, v31
    v_exp_f32 v31, v31
    s_nop 0
    v_cvt_pk_bf16_f32 v16, v16, v17
    v_cvt_pk_bf16_f32 v17, v18, v19
    v_cvt_pk_bf16_f32 v18, v20, v21
    v_cvt_pk_bf16_f32 v19, v22, v23
    v_cvt_pk_bf16_f32 v24, v24, v25
    v_cvt_pk_bf16_f32 v25, v26, v27
    v_cvt_pk_bf16_f32 v26, v28, v29
    v_cvt_pk_bf16_f32 v27, v30, v31
    s_nop 1
    v_mfma_f32_32x32x16_bf16 v[64:79], v[96:99], v[16:19], v[64:79]
    v_mfma_f32_32x32x16_bf16 v[64:79], v[100:103], v[24:27], v[64:79]
    s_nop 7
L_s_next:
    v_add_u32 v104, 3072, v104
    v_add_u32 v105, 3072, v105
    v_add_u32 v106, 3072, v106
    s_add_u32 s43, s43, 1
    s_cmp_lt_u32 s43, 8
    s_cbranch_scc1 L_s_tile
    v_subrev_u32 v104, 24576, v104
    v_subrev_u32 v105, 24576, v105
    v_subrev_u32 v106, 24576, v106
    s_add_u32 s18, s18, 2560
    s_add_u32 s19, s19, 1
    s_cmp_lt_u32 s19, 4
    s_cbranch_scc1 L_s_round
    s_cmp_eq_u32 s44, 1
    s_cbranch_scc1 L_s_fin
    v_mov_b32 v32, v42
    v_mov_b32 v33, v42
    s_nop 1
    v_permlane32_swap_b32 v32, v33
    s_nop 1
    v_max_f32 v42, v32, v33
    v_mov_b32 v32, v43
    v_mov_b32 v33, v43
    s_nop 1
    v_permlane32_swap_b32 v32, v33
    s_nop 1
    v_max_f32 v43, v32, v33
    s_barrier
    ds_write_b64 v109, v[42:43]
    s_waitcnt lgkmcnt(0)
    s_barrier
    ds_read_b64 v[36:37], v122
    s_waitcnt lgkmcnt(0)
    v_max_f32 v42, v42, v37
    v_max_f32 v43, v43, v36
    s_mov_b32 s44, 1
    s_branch L_s_pass
L_s_fin:
    s_waitcnt lgkmcnt(0)
    s_barrier
    s_branch L_epi
L_end:
s_endpgm
.section .rodata,"a"
.p2align 6
.amdhsa_kernel standalone__qk_norm__prompt_kernel
  .amdhsa_next_free_vgpr 128
  .amdhsa_next_free_sgpr 102
  .amdhsa_accum_offset 128
  .amdhsa_group_segment_fixed_size 0
  .amdhsa_kernarg_size 56
  .amdhsa_user_sgpr_count 2
  .amdhsa_user_sgpr_kernarg_segment_ptr 1
  .amdhsa_system_sgpr_workgroup_id_x 1
.end_amdhsa_kernel
```
